```python
import torch

def _softmax(x, axis=-1):
    return torch.softmax(x, dim=axis)
def _gelu(x):
    return torch.nn.functional.gelu(x, approximate="tanh")
def _silu(x):
    return torch.nn.functional.silu(x)
def _sigmoid(x):
    return torch.sigmoid(x)
def _layernorm(x, axis=-1, eps=1e-5):
    m = x.mean(dim=axis, keepdim=True)
    v = x.var(dim=axis, keepdim=True, unbiased=False)
    return (x - m) / torch.sqrt(v + eps)
def _scatter_add(tgt, idx, src, axis=0):
    return tgt.clone().index_add_(axis, idx, src)
def _segment_sum(src, seg, n):
    out = torch.zeros((n,) + src.shape[1:], dtype=src.dtype)
    return out.index_add_(0, seg, src)
def _pad(x, pw):
    flat = tuple(v for pair in reversed(pw) for v in pair)
    return torch.nn.functional.pad(x, flat)

kernel_name = 'standalone__paged_block_table_kv_radixattention__decode'

def setup_inputs():

    _w = (lambda a: (lambda t: t.to(torch.bfloat16) if t.is_floating_point() else t)(torch.as_tensor(a)))
    B, H, Hkv, Dh = 2, 32, 8, 128
    Lk = 32768
    bs = 16
    nb = max(2, Lk // bs)
    P = max(1, nb // 2)
    n_phys = P + B * (nb - P)
    shared = torch.arange(P, dtype=torch.int64)
    priv = P + torch.arange(B * (nb - P), dtype=torch.int64).reshape(B, nb - P)
    bt = torch.cat([torch.tile(shared[None, :], (B, 1)), priv], dim=1)
    ctx = nb * bs - (torch.arange(1, B + 1, dtype=torch.int64) * 2654435761) % max(1, (nb * bs - P * bs) // 2)
    return {
        "q": _w((lambda *s: torch.randn(*s, dtype=torch.bfloat16) * 0.8)(B, H, Dh)),
        "k_cache": _w((lambda *s: torch.randn(*s, dtype=torch.bfloat16) * 0.8)(n_phys, bs, Hkv, Dh)),
        "v_cache": _w((lambda *s: torch.randn(*s, dtype=torch.bfloat16) * 0.05)(n_phys, bs, Hkv, Dh)),
        "block_table": _w(bt.to(torch.int64)),
        "ctx_lens": _w(torch.as_tensor(ctx).to(torch.int64)),
    }

def reference(q, k_cache, v_cache, block_table, ctx_lens):
    B, H, Dh = q.shape
    n_phys, bs, Hkv, _ = k_cache.shape
    nb = block_table.shape[1]
    Lk = nb * bs
    rep = H // Hkv
    k = k_cache[block_table].reshape(B, Lk, Hkv, Dh)
    v = v_cache[block_table].reshape(B, Lk, Hkv, Dh)
    k = (lambda x, n, axis: torch.repeat_interleave(x, n, dim=axis))(k, rep, axis=2)
    v = (lambda x, n, axis: torch.repeat_interleave(x, n, dim=axis))(v, rep, axis=2)
    scores = torch.einsum("bhd,bkhd->bhk", q, k) * (Dh ** -0.5)
    pos = torch.arange(Lk)
    valid = pos[None, :] < ctx_lens[:, None]
    scores = torch.where(valid[:, None, :], scores, -1e9)
    p = _softmax(scores, axis=-1)
    return torch.einsum("bhk,bkhd->bhd", p, v)
```

```asm
; @launch grid=(256,1,1) block=(320,1,1) lds=66816
.amdgcn_target "amdgcn-amd-amdhsa--gfx950"
.text
.p2align 12
L_misspec:
    v_readfirstlane_b32 s59, v21
    v_readfirstlane_b32 s60, v22
    v_readfirstlane_b32 s61, v23
    s_waitcnt vmcnt(0)
    s_mov_b32 m0, 0
    s_and_b32 s52, s58, s55
    s_and_b32 s53, s59, s55
    s_and_b32 s7, s59, s56
    s_cselect_b32 s34, s54, 0
    s_cselect_b32 s50, s54, 0
    s_and_b32 s7, s58, s56
    s_cselect_b32 s30, s54, 0
    s_cselect_b32 s38, s54, 0
    buffer_load_dwordx4 v8, s[28:31], s52 offen offset:0 nt lds
    buffer_load_dwordx4 v9, s[28:31], s52 offen offset:1024 nt lds
    buffer_load_dwordx4 v10, s[28:31], s52 offen offset:2048 nt lds
    buffer_load_dwordx4 v11, s[28:31], s52 offen offset:3072 nt lds
    s_addk_i32 m0, 4096
    s_nop 0
    buffer_load_dwordx4 v8, s[32:35], s53 offen offset:0 nt lds
    buffer_load_dwordx4 v9, s[32:35], s53 offen offset:1024 nt lds
    buffer_load_dwordx4 v10, s[32:35], s53 offen offset:2048 nt lds
    buffer_load_dwordx4 v11, s[32:35], s53 offen offset:3072 nt lds
    s_addk_i32 m0, 4096
    s_nop 0
    buffer_load_dwordx4 v12, s[36:39], s52 offen offset:0 nt lds
    buffer_load_dwordx4 v13, s[36:39], s52 offen offset:1024 nt lds
    buffer_load_dwordx4 v14, s[36:39], s52 offen offset:2048 nt lds
    buffer_load_dwordx4 v15, s[36:39], s52 offen offset:3072 nt lds
    s_addk_i32 m0, 4096
    s_nop 0
    buffer_load_dwordx4 v12, s[48:51], s53 offen offset:0 nt lds
    buffer_load_dwordx4 v13, s[48:51], s53 offen offset:1024 nt lds
    buffer_load_dwordx4 v14, s[48:51], s53 offen offset:2048 nt lds
    buffer_load_dwordx4 v15, s[48:51], s53 offen offset:3072 nt lds
    s_addk_i32 m0, 4096
    s_nop 0
    s_and_b32 s52, s60, s55
    s_and_b32 s53, s61, s55
    s_and_b32 s7, s61, s56
    s_cselect_b32 s34, s54, 0
    s_cselect_b32 s50, s54, 0
    s_and_b32 s7, s60, s56
    s_cselect_b32 s30, s54, 0
    s_cselect_b32 s38, s54, 0
    buffer_load_dwordx4 v8, s[28:31], s52 offen offset:0 nt lds
    buffer_load_dwordx4 v9, s[28:31], s52 offen offset:1024 nt lds
    buffer_load_dwordx4 v10, s[28:31], s52 offen offset:2048 nt lds
    buffer_load_dwordx4 v11, s[28:31], s52 offen offset:3072 nt lds
    s_addk_i32 m0, 4096
    s_nop 0
    buffer_load_dwordx4 v8, s[32:35], s53 offen offset:0 nt lds
    buffer_load_dwordx4 v9, s[32:35], s53 offen offset:1024 nt lds
    buffer_load_dwordx4 v10, s[32:35], s53 offen offset:2048 nt lds
    buffer_load_dwordx4 v11, s[32:35], s53 offen offset:3072 nt lds
    s_addk_i32 m0, 4096
    s_nop 0
    buffer_load_dwordx4 v12, s[36:39], s52 offen offset:0 nt lds
    buffer_load_dwordx4 v13, s[36:39], s52 offen offset:1024 nt lds
    buffer_load_dwordx4 v14, s[36:39], s52 offen offset:2048 nt lds
    s_waitcnt vmcnt(19)
    s_barrier
    s_branch L_enter
L_qzero:
    s_cmp_gt_i32 s40, 0
    s_cselect_b32 s68, 0, 0x0f0f0f0f
    s_cmp_gt_i32 s41, 0
    s_cselect_b32 s69, 0, 0xf0f0f0f0
    s_or_b32 s68, s68, s69
    s_mov_b32 s69, s68
    s_waitcnt lgkmcnt(0)
    v_cndmask_b32 v64, v64, 0, s[68:69]
    v_cndmask_b32 v65, v65, 0, s[68:69]
    v_cndmask_b32 v66, v66, 0, s[68:69]
    v_cndmask_b32 v67, v67, 0, s[68:69]
    v_cndmask_b32 v68, v68, 0, s[68:69]
    v_cndmask_b32 v69, v69, 0, s[68:69]
    v_cndmask_b32 v70, v70, 0, s[68:69]
    v_cndmask_b32 v71, v71, 0, s[68:69]
    v_cndmask_b32 v72, v72, 0, s[68:69]
    v_cndmask_b32 v73, v73, 0, s[68:69]
    v_cndmask_b32 v74, v74, 0, s[68:69]
    v_cndmask_b32 v75, v75, 0, s[68:69]
    v_cndmask_b32 v76, v76, 0, s[68:69]
    v_cndmask_b32 v77, v77, 0, s[68:69]
    v_cndmask_b32 v78, v78, 0, s[68:69]
    v_cndmask_b32 v79, v79, 0, s[68:69]
    s_branch L_q_ok
.fill 700, 4, 0xbf810000
.globl standalone__paged_block_table_kv_radixattention__decode_kernel
.p2align 8
.type standalone__paged_block_table_kv_radixattention__decode_kernel,@function
standalone__paged_block_table_kv_radixattention__decode_kernel:
    s_lshr_b32 s6, s2, 8
    s_cbranch_scc1 L_exit
    s_load_dwordx16 s[8:23], s[0:1], 0
    v_lshrrev_b32 v1, 6, v0
    s_lshr_b32 s6, s2, 5
    s_xor_b32 s6, s6, s2
    v_readfirstlane_b32 s3, v1
    s_and_b32 s4, s6, 7
    s_lshr_b32 s5, s2, 3
    s_lshl_b32 s74, s4, 8
    v_and_b32 v1, 63, v0
    s_movk_i32 s24, 0x4000
    s_mov_b32 s25, 0x00020000
    v_lshrrev_b32 v2, 4, v1
    v_and_b32 v3, 15, v1
    s_cmp_eq_u32 s3, 0
    s_cbranch_scc1 L_loader
    s_bitset1_b32 s74, 20
    s_cmp_eq_u32 s3, 2
    s_cbranch_scc1 L_touch1
    s_cmp_eq_u32 s3, 3
    s_cbranch_scc1 L_touch2
    s_cmp_eq_u32 s3, 4
    s_cbranch_scc1 L_touch3
    s_lshl_b32 s6, s5, 2
    v_lshl_add_u32 v12, v1, 7, s6
    s_and_b32 s6, s6, 4
    s_addk_i32 s6, 768
    v_lshl_add_u32 v14, v1, 4, s6
    v_lshlrev_b32 v4, 1, v2
    v_xor_b32 v4, v4, v3
    s_lshl_b32 s6, s4, 10
    v_lshl_add_u32 v5, v2, 8, s6
    v_lshl_add_u32 v4, v4, 4, v5
    v_xor_b32 v5, 128, v4
    s_mov_b32 m0, 49152
    s_movk_i32 s71, 8192
    s_movk_i32 s6, 7168
    s_waitcnt lgkmcnt(0)
    s_mov_b64 s[12:13], s[14:15]
    s_mov_b64 s[14:15], s[24:25]
    s_load_dwordx2 s[40:41], s[16:17], 0
    s_load_dword s42, s[22:23], s74
    buffer_load_dword v80, v12, s[12:15], 0 offen
    buffer_load_dword v81, v12, s[12:15], s71 offen
    s_mov_b64 s[10:11], s[24:25]
    buffer_load_dword v82, v14, s[12:15], 0 offen
    buffer_load_dword v83, v14, s[12:15], 0 offen offset:8
    buffer_load_dword v84, v14, s[12:15], s71 offen
    buffer_load_dword v85, v14, s[12:15], s71 offen offset:8
    buffer_load_dwordx4 v4, s[8:11], 0 offen lds
    buffer_load_dwordx4 v5, s[8:11], s6 offen offset:1024 lds
    s_branch L_cons
L_eb:
    s_waitcnt lgkmcnt(0)
    s_load_dwordx2 s[40:41], s[16:17], 0
    s_load_dword s42, s[22:23], s74
    s_branch L_cons
L_loader:
    s_setprio 3
    v_lshl_add_u32 v4, v2, 11, s74
    v_xor_b32 v8, v2, v3
    v_lshl_add_u32 v8, v8, 4, v4
    v_lshlrev_b32 v5, 1, v2
    v_xor_b32 v12, v5, v3
    v_lshl_add_u32 v12, v12, 4, v4
    s_movk_i32 s6, 7168
    s_movk_i32 s7, 14336
    v_xad_u32 v9, v8, 64, s6
    v_xor_b32 v10, 128, v8
    v_add_u32 v10, s7, v10
    v_xad_u32 v11, v10, 64, s6
    v_xor_b32 v13, 128, v12
    v_add_u32 v14, s7, v12
    v_add_u32 v13, s6, v13
    v_add_u32 v15, s7, v13
    s_lshl_b32 s62, s5, 15
    s_bitset1_b32 s74, 20
    s_add_u32 s63, s62, 1048576
    s_add_u32 s52, s62, 2097152
    s_add_u32 s53, s62, 3145728
    s_mov_b32 s54, 100663296
    s_mov_b32 s30, s54
    s_mov_b32 s31, s25
    s_mov_b64 s[34:35], s[30:31]
    s_mov_b64 s[38:39], s[30:31]
    s_mov_b64 s[50:51], s[30:31]
    s_mov_b32 m0, 0
    s_waitcnt lgkmcnt(0)
    s_mov_b64 s[28:29], s[10:11]
    s_mov_b64 s[32:33], s[10:11]
    s_mov_b64 s[36:37], s[12:13]
    s_mov_b64 s[48:49], s[12:13]
    buffer_load_dwordx4 v8, s[28:31], s62 offen offset:0 nt lds
    buffer_load_dwordx4 v9, s[28:31], s62 offen offset:1024 nt lds
    buffer_load_dwordx4 v10, s[28:31], s62 offen offset:2048 nt lds
    buffer_load_dwordx4 v11, s[28:31], s62 offen offset:3072 nt lds
    s_addk_i32 m0, 4096
    s_load_dword s42, s[22:23], s74
    buffer_load_dwordx4 v8, s[32:35], s63 offen offset:0 nt lds
    buffer_load_dwordx4 v9, s[32:35], s63 offen offset:1024 nt lds
    buffer_load_dwordx4 v10, s[32:35], s63 offen offset:2048 nt lds
    buffer_load_dwordx4 v11, s[32:35], s63 offen offset:3072 nt lds
    s_addk_i32 m0, 4096
    s_mov_b64 s[44:45], s[22:23]
    buffer_load_dwordx4 v12, s[36:39], s62 offen offset:0 nt lds
    buffer_load_dwordx4 v13, s[36:39], s62 offen offset:1024 nt lds
    buffer_load_dwordx4 v14, s[36:39], s62 offen offset:2048 nt lds
    buffer_load_dwordx4 v15, s[36:39], s62 offen offset:3072 nt lds
    s_addk_i32 m0, 4096
    s_mov_b32 s46, 8388608
    buffer_load_dwordx4 v12, s[48:51], s63 offen offset:0 nt lds
    buffer_load_dwordx4 v13, s[48:51], s63 offen offset:1024 nt lds
    buffer_load_dwordx4 v14, s[48:51], s63 offen offset:2048 nt lds
    buffer_load_dwordx4 v15, s[48:51], s63 offen offset:3072 nt lds
    s_addk_i32 m0, 4096
    s_mov_b32 s47, s25
    buffer_load_dwordx4 v8, s[28:31], s52 offen offset:0 nt lds
    buffer_load_dwordx4 v9, s[28:31], s52 offen offset:1024 nt lds
    buffer_load_dwordx4 v10, s[28:31], s52 offen offset:2048 nt lds
    buffer_load_dwordx4 v11, s[28:31], s52 offen offset:3072 nt lds
    s_addk_i32 m0, 4096
    s_mov_b64 s[16:17], s[18:19]
    buffer_load_dwordx4 v8, s[32:35], s53 offen offset:0 nt lds
    buffer_load_dwordx4 v9, s[32:35], s53 offen offset:1024 nt lds
    buffer_load_dwordx4 v10, s[32:35], s53 offen offset:2048 nt lds
    buffer_load_dwordx4 v11, s[32:35], s53 offen offset:3072 nt lds
    s_addk_i32 m0, 4096
    s_mov_b64 s[18:19], s[24:25]
    buffer_load_dwordx4 v12, s[36:39], s52 offen offset:0 nt lds
    buffer_load_dwordx4 v13, s[36:39], s52 offen offset:1024 nt lds
    buffer_load_dwordx4 v14, s[36:39], s52 offen offset:2048 nt lds
    s_movk_i32 s55, 0x8000
    s_movk_i32 s56, 0x3ff
    v_mov_b32 v16, 65536
    v_lshlrev_b32 v17, 4, v0
    s_lshl_b32 s68, s4, 5
    s_add_u32 s68, s68, s5
    s_lshl_b32 s68, s68, 12
    v_and_b32 v4, 4, v0
    v_and_b32 v5, 3, v0
    v_lshlrev_b32 v4, 11, v4
    v_lshl_add_u32 v18, v5, 8, v4
    v_and_b32 v4, 1, v2
    v_and_b32 v5, 2, v2
    v_lshl_add_u32 v18, v4, 2, v18
    v_add_u32 v18, v5, v18
    s_mov_b32 s40, 0x00ff00ff
    s_mov_b32 s41, s40
    s_lshl_b32 s69, s4, 10
    s_lshl3_add_u32 s69, s5, s69
    s_waitcnt vmcnt(19) lgkmcnt(0)
    s_add_u32 s42, s42, 0x6b43a9b5
    s_barrier
    ds_read_b128 v[20:23], v16
    v_add_u32 v16, 16, v16
    s_waitcnt lgkmcnt(0)
    v_readfirstlane_b32 s58, v20
    s_bitcmp1_b32 s58, 11
    s_cbranch_scc1 L_enter
    s_branch L_misspec
L_round:
    s_waitcnt vmcnt(19)
    buffer_load_dwordx4 v8, s[28:31], s52 offen offset:0 nt lds
    s_waitcnt vmcnt(19)
    buffer_load_dwordx4 v9, s[28:31], s52 offen offset:1024 nt lds
    s_waitcnt vmcnt(19)
    buffer_load_dwordx4 v10, s[28:31], s52 offen offset:2048 nt lds
    s_waitcnt vmcnt(19)
    buffer_load_dwordx4 v11, s[28:31], s52 offen offset:3072 nt lds
    s_addk_i32 m0, 4096
    s_waitcnt vmcnt(19)
    buffer_load_dwordx4 v8, s[32:35], s53 offen offset:0 nt lds
    s_waitcnt vmcnt(19)
    buffer_load_dwordx4 v9, s[32:35], s53 offen offset:1024 nt lds
    s_waitcnt vmcnt(19)
    buffer_load_dwordx4 v10, s[32:35], s53 offen offset:2048 nt lds
    s_waitcnt vmcnt(19)
    buffer_load_dwordx4 v11, s[32:35], s53 offen offset:3072 nt lds
    s_addk_i32 m0, 4096
    s_waitcnt vmcnt(19)
    buffer_load_dwordx4 v12, s[36:39], s52 offen offset:0 nt lds
    s_waitcnt vmcnt(19)
    buffer_load_dwordx4 v13, s[36:39], s52 offen offset:1024 nt lds
    s_waitcnt vmcnt(19)
    buffer_load_dwordx4 v14, s[36:39], s52 offen offset:2048 nt lds
    s_waitcnt vmcnt(19)
    s_barrier
L_enter:
    ds_read_b64 v[20:21], v16
    v_add_u32 v16, 8, v16
    buffer_load_dwordx4 v15, s[36:39], s52 offen offset:3072 nt lds
    s_addk_i32 m0, 4096
    s_waitcnt vmcnt(19)
    buffer_load_dwordx4 v12, s[48:51], s53 offen offset:0 nt lds
    s_branch L_over1
L_touch1:
    s_branch L_eb
L_over1:
    s_waitcnt vmcnt(19)
    buffer_load_dwordx4 v13, s[48:51], s53 offen offset:1024 nt lds
    s_waitcnt vmcnt(19)
    buffer_load_dwordx4 v14, s[48:51], s53 offen offset:2048 nt lds
    s_waitcnt vmcnt(19)
    buffer_load_dwordx4 v15, s[48:51], s53 offen offset:3072 nt lds
    s_addk_i32 m0, 4096
    s_waitcnt lgkmcnt(0)
    v_readfirstlane_b32 s58, v20
    v_readfirstlane_b32 s59, v21
    s_bitset0_b32 m0, 16
    s_and_b32 s52, s58, s55
    s_and_b32 s53, s59, s55
    s_and_b32 s7, s59, s56
    s_cselect_b32 s34, s54, 0
    s_cselect_b32 s50, s54, 0
    s_and_b32 s7, s58, s56
    s_cselect_b32 s30, s54, 0
    s_cselect_b32 s38, s54, 0
    s_cmp_lg_u32 s58, 0
    s_cbranch_scc1 L_round
    v_and_b32 v22, 31, v0
    v_lshrrev_b32 v23, 5, v0
    v_lshlrev_b32 v22, 12, v22
    v_lshl_add_u32 v22, v23, 6, v22
    s_lshl_b32 s6, s4, 10
    s_add_u32 s6, s6, s5
    s_lshl_b32 s6, s6, 7
    buffer_load_dword v21, v22, s[44:47], s6 offen
    s_waitcnt vmcnt(9)
    s_barrier
    s_waitcnt vmcnt(1)
    s_barrier
    s_mov_b32 s60, 200000
    s_mov_b64 s[52:53], -1
    s_mov_b64 s[54:55], -1
    s_mov_b64 s[56:57], -1
    s_mov_b64 s[58:59], -1
    s_barrier
L_poll:
    s_wqm_b64 exec, s[52:53]
    buffer_load_dwordx4 v[24:27], v17, s[44:47], s68 offen offset:0 sc1
    s_wqm_b64 exec, s[54:55]
    buffer_load_dwordx4 v[28:31], v17, s[44:47], s68 offen offset:1024 sc1
    s_wqm_b64 exec, s[56:57]
    buffer_load_dwordx4 v[32:35], v17, s[44:47], s68 offen offset:2048 sc1
    s_wqm_b64 exec, s[58:59]
    buffer_load_dwordx4 v[36:39], v17, s[44:47], s68 offen offset:3072 sc1
    s_mov_b64 exec, -1
    s_sub_u32 s60, s60, 1
    s_cbranch_scc1 L_ready
    s_waitcnt vmcnt(0)
    v_cmp_ne_u32 s[52:53], s42, v27
    v_cmp_ne_u32 s[54:55], s42, v31
    v_cmp_ne_u32 s[56:57], s42, v35
    v_cmp_ne_u32 s[58:59], s42, v39
    s_or_b64 vcc, s[52:53], s[54:55]
    s_or_b64 vcc, vcc, s[56:57]
    s_or_b64 vcc, vcc, s[58:59]
    s_cbranch_scc1 L_poll
L_ready:
    v_max3_f32 v72, v26, v30, v34
    s_mov_b32 s60, 0xffff0000
    v_max_f32 v72, v72, v38
    v_lshlrev_b32 v80, 16, v24
    v_and_b32 v81, s60, v24
    v_max_f32_dpp v72, v72, v72 row_ror:8 row_mask:0xf bank_mask:0xf
    v_mov_b32 v73, v72
    v_lshlrev_b32 v82, 16, v25
    v_and_b32 v83, s60, v25
    v_permlane16_swap_b32 v72, v73
    v_lshlrev_b32 v84, 16, v28
    v_max_f32 v72, v72, v73
    v_mov_b32 v73, v72
    v_and_b32 v85, s60, v28
    v_lshlrev_b32 v86, 16, v29
    v_permlane32_swap_b32 v72, v73
    v_and_b32 v87, s60, v29
    v_max_f32 v72, v72, v73
    v_sub_f32 v26, v26, v72
    v_sub_f32 v30, v30, v72
    v_sub_f32 v34, v34, v72
    v_sub_f32 v38, v38, v72
    v_exp_f32 v26, v26
    v_lshlrev_b32 v88, 16, v32
    v_and_b32 v89, s60, v32
    v_exp_f32 v30, v30
    v_lshlrev_b32 v90, 16, v33
    v_and_b32 v91, s60, v33
    v_exp_f32 v34, v34
    v_lshlrev_b32 v92, 16, v36
    v_and_b32 v93, s60, v36
    v_exp_f32 v38, v38
    v_lshlrev_b32 v94, 16, v37
    v_and_b32 v95, s60, v37
    v_add_f32 v74, v26, v30
    v_add_f32 v73, v34, v38
    v_pk_mul_f32 v[96:97], v[80:81], v[26:27] op_sel_hi:[1,0]
    v_add_f32 v74, v74, v73
    v_pk_mul_f32 v[98:99], v[82:83], v[26:27] op_sel_hi:[1,0]
    v_pk_fma_f32 v[96:97], v[84:85], v[30:31], v[96:97] op_sel_hi:[1,0,1]
    v_add_f32_dpp v74, v74, v74 row_ror:8 row_mask:0xf bank_mask:0xf
    v_mov_b32 v73, v74
    v_pk_fma_f32 v[98:99], v[86:87], v[30:31], v[98:99] op_sel_hi:[1,0,1]
    v_pk_fma_f32 v[96:97], v[88:89], v[34:35], v[96:97] op_sel_hi:[1,0,1]
    v_permlane16_swap_b32 v74, v73
    v_pk_fma_f32 v[98:99], v[90:91], v[34:35], v[98:99] op_sel_hi:[1,0,1]
    v_add_f32 v74, v74, v73
    v_mov_b32 v73, v74
    v_pk_fma_f32 v[96:97], v[92:93], v[38:39], v[96:97] op_sel_hi:[1,0,1]
    v_pk_fma_f32 v[98:99], v[94:95], v[38:39], v[98:99] op_sel_hi:[1,0,1]
    v_permlane32_swap_b32 v74, v73
    v_permlane32_swap_b32 v96, v97
    v_permlane32_swap_b32 v98, v99
    v_add_f32 v74, v74, v73
    v_add_f32 v96, v96, v97
    v_add_f32 v98, v98, v99
    v_rcp_f32 v74, v74
    s_nop 0
    v_permlane16_swap_b32 v96, v98
    v_mov_b32 v78, s42
    v_add_f32 v96, v96, v98
    v_mov_b32 v79, 0
    s_cmp_lg_u32 s5, 0
    v_add_f32_dpp v96, v96, v96 row_ror:8 row_mask:0xf bank_mask:0xf
    v_mul_f32 v96, v96, v74
    v_cvt_pk_bf16_f32 v76, v96, v96
    s_mov_b64 exec, s[40:41]
    buffer_store_short v76, v18, s[16:19], s69 offen
    s_cbranch_scc1 L_noep
    s_mov_b64 exec, 1
    buffer_store_dword v78, v79, s[44:47], s74 offen
L_noep:
L_exit:
    s_endpgm
L_cons:
    s_sub_u32 s52, s3, 1
    s_mov_b64 s[44:45], s[22:23]
    s_mov_b32 s46, 8388608
    s_mov_b32 s47, s25
    v_mov_b32 v15, 0
    v_mov_b32 v13, 65536
    s_brev_b32 s55, -2
    s_cmp_lg_u32 s52, 0
    s_cbranch_scc1 L_nobuild
    v_cmp_gt_u32 vcc, 2, v1
    v_mov_b32 v37, 0x400
    v_lshl_add_u32 v4, v1, 4, v13
    v_cndmask_b32 v36, 0, v37, vcc
    v_lshl_add_u32 v5, v1, 2, v13
    v_mov_b32 v37, v36
    v_mov_b32 v38, v36
    v_mov_b32 v39, v36
    s_and_b32 s7, s5, 1
    s_lshl_b32 s58, s4, 1
    s_add_u32 s58, s58, s7
    s_lshl_b32 s58, s58, 8
    s_add_u32 s58, s58, 1052672
    v_lshrrev_b32 v68, 2, v12
    v_lshlrev_b32 v21, 2, v12
    s_waitcnt lgkmcnt(0)
    ds_write_b128 v4, v[36:39]
    ds_write_b32 v5, v15 offset:1024
    s_add_u32 s6, s40, -1
    s_add_u32 s7, s41, -1
    s_movk_i32 s59, 0x7fff
    s_min_u32 s6, s6, s59
    s_min_u32 s7, s7, s59
    s_add_u32 s66, s6, 1
    s_add_u32 s67, s7, 1
    v_sub_u32 v64, s66, v21
    v_sub_u32 v65, s67, v21
    s_add_u32 s72, s42, 0x6b43a9b5
    s_and_b32 s72, s72, 0xffffff
    v_mov_b32 v21, s72
    s_cmp_lt_u32 s5, 2
    s_cselect_b32 s46, s46, 0
    s_mov_b64 exec, 1
    buffer_atomic_swap v21, v15, s[44:47], s58 offen sc0 sc1
    s_mov_b64 exec, -1
    s_bitset1_b32 s46, 23
    v_med3_i32 v64, v64, 0, 16
    v_med3_i32 v65, v65, 0, 16
    v_cmp_lt_u32 s[60:61], 0, v64
    v_cmp_lt_u32 s[62:63], 0, v65
    v_lshlrev_b32 v65, 5, v65
    s_andn2_b32 s64, s60, 0xfc0
    s_mov_b32 s65, s61
    s_bcnt1_i32_b64 s59, s[64:65]
    v_mbcnt_lo_u32_b32 v4, s64, 0
    v_mbcnt_hi_u32_b32 v4, s65, v4
    v_mov_b32 v5, s59
    v_lshl_add_u32 v4, v4, 2, v13
    s_waitcnt vmcnt(7)
    v_cmp_eq_u32 vcc, v80, v68
    v_lshl_or_b32 v66, v80, 15, v64
    s_nand_b32 s6, vcc_lo, s64
    v_cmp_eq_u32 vcc, v80, v81
    s_and_b32 s6, s6, 15
    s_cselect_b32 s6, 0, 0x800
    v_lshl_or_b32 v67, v81, 15, v65
    s_and_b64 vcc, vcc, s[60:61]
    s_andn2_b64 s[62:63], s[62:63], vcc
    v_cndmask_b32 v68, 0, v65, vcc
    v_mbcnt_lo_u32_b32 v5, s62, v5
    v_or3_b32 v66, v66, v68, s6
    v_mbcnt_hi_u32_b32 v5, s63, v5
    v_lshl_add_u32 v5, v5, 2, v13
    s_mov_b64 exec, s[64:65]
    ds_write_b32 v4, v66
    s_mov_b64 exec, s[62:63]
    ds_write_b32 v5, v67
    s_mov_b64 exec, -1
    s_bcnt1_i32_b64 s7, s[62:63]
    s_add_u32 s59, s59, s7
    s_max_u32 s59, s59, 8
    v_lshlrev_b32 v4, 2, v14
    s_branch L_over2
L_touch2:
    s_branch L_eb
L_over2:
    s_lshl_b32 s6, s59, 2
    v_add_u32 v14, s6, v13
    s_mov_b32 s57, 0
    s_bfm_b64 exec, 48, 0
    s_waitcnt vmcnt(3)
    v_sub_u32 v64, s66, v4
    v_sub_u32 v65, s67, v4
    v_cmp_eq_u32 vcc, v82, v84
    v_med3_i32 v64, v64, 0, 16
    v_med3_i32 v65, v65, 0, 16
    v_lshl_or_b32 v66, v82, 15, v64
    v_cndmask_b32 v65, 0, v65, vcc
    v_cmp_lt_u32 vcc, 0, v64
    v_lshl_or_b32 v66, v65, 5, v66
    s_bcnt1_i32_b64 s6, vcc
    v_cndmask_b32 v16, 0, v66, vcc
    s_add_u32 s57, s57, s6
    v_add_u32 v4, 32, v4
    v_sub_u32 v64, s66, v4
    v_sub_u32 v65, s67, v4
    v_cmp_eq_u32 vcc, v83, v85
    v_med3_i32 v64, v64, 0, 16
    v_med3_i32 v65, v65, 0, 16
    v_lshl_or_b32 v66, v83, 15, v64
    v_cndmask_b32 v65, 0, v65, vcc
    v_cmp_lt_u32 vcc, 0, v64
    v_lshl_or_b32 v66, v65, 5, v66
    s_bcnt1_i32_b64 s6, vcc
    v_cndmask_b32 v17, 0, v66, vcc
    s_add_u32 s57, s57, s6
    s_mov_b64 exec, -1
    s_lshr_b32 s6, s59, 1
    s_sub_u32 s6, s6, 4
    s_cmp_lg_u32 s57, 0
    s_cselect_b32 s55, s6, s55
L_nobuild:
    v_and_b32 v5, 7, v3
    v_lshlrev_b32 v4, 1, v5
    v_xor_b32 v4, v4, v2
    v_lshlrev_b32 v20, 4, v5
    v_add_lshl_u32 v40, v20, v4, 4
    v_xor_b32 v4, v2, v3
    v_lshlrev_b32 v4, 4, v4
    v_lshl_add_u32 v22, v3, 8, v4
    s_movk_i32 s6, 128
    v_xor_b32 v41, 64, v40
    v_xor_b32 v42, s6, v40
    v_xor_b32 v43, s6, v41
    v_xor_b32 v23, 64, v22
    v_xor_b32 v24, s6, v22
    v_xor_b32 v25, s6, v23
    v_lshlrev_b32 v10, 2, v2
    v_lshrrev_b32 v4, 3, v3
    v_lshl_add_u32 v4, v4, 2, v2
    v_lshl_add_u32 v20, v4, 12, v20
    v_lshrrev_b32 v4, 2, v1
    v_and_b32 v5, 3, v1
    v_lshlrev_b32 v5, 3, v5
    v_lshl_add_u32 v5, v4, 8, v5
    v_and_b32 v9, 1, v4
    v_and_b32 v4, 7, v4
    s_lshl_b32 s6, s52, 1
    v_xor_b32 v4, s6, v4
    v_lshl_add_u32 v26, v4, 5, v5
    v_xor_b32 v27, 32, v26
    v_mul_u32_u24 v9, 5, v9
    v_mov_b32 v6, 0xec800000
    s_mov_b32 s53, 0x3e0293ee
    v_mov_b32 v7, 0
    v_mov_b64 v[44:45], 0
    v_mov_b64 v[46:47], 0
    v_mov_b64 v[48:49], 0
    v_mov_b64 v[50:51], 0
    v_mov_b64 v[52:53], 0
    v_mov_b64 v[54:55], 0
    v_mov_b64 v[56:57], 0
    v_mov_b64 v[58:59], 0
    v_mov_b64 v[60:61], 0
    v_mov_b64 v[62:63], 0
    v_mov_b32 v28, v22
    v_mov_b32 v29, v23
    v_mov_b32 v30, v24
    v_mov_b32 v31, v25
    s_mov_b32 s54, 0
    s_mov_b32 s56, 0
    s_lshl2_add_u32 s70, s4, s52
    s_lshl_b32 s70, s70, 8
    s_add_u32 s70, s70, s5
    s_lshl_b32 s70, s70, 7
    v_mul_f32 v8, s53, v6
    s_waitcnt vmcnt(1) lgkmcnt(0)
    s_min_i32 s6, s40, s41
    s_barrier
    ds_read_b64 v[18:19], v13
    ds_read_b128 v[64:67], v40 offset:49152
    ds_read_b128 v[68:71], v41 offset:49152
    ds_read_b128 v[72:75], v42 offset:49152
    ds_read_b128 v[76:79], v43 offset:49152
    s_waitcnt lgkmcnt(4)
    v_readfirstlane_b32 s59, v18
    s_cmp_gt_i32 s6, 0
    s_cbranch_scc0 L_qzero
L_q_ok:
    s_bitcmp1_b32 s59, 11
    s_cbranch_scc1 L_k
    s_barrier
    s_branch L_k
L_r:
    s_barrier
    ds_read_b64_tr_b16 v[48:49], v32 offset:8192
    ds_read_b64_tr_b16 v[50:51], v32 offset:12288
    ds_read_b64_tr_b16 v[52:53], v33 offset:8192
    ds_read_b64_tr_b16 v[54:55], v33 offset:12288
L_k:
    ds_read_b128 v[80:83], v28
    ds_read_b128 v[96:99], v28 offset:4096
    ds_read_b128 v[84:87], v29
    ds_read_b128 v[100:103], v29 offset:4096
    ds_read_b128 v[88:91], v30
    ds_read_b128 v[104:107], v30 offset:4096
    ds_read_b128 v[92:95], v31
    ds_read_b128 v[108:111], v31 offset:4096
    v_bfe_u32 v2, v18, v9, 5
    v_sub_u32 v2, v2, v10
    v_bfe_u32 v3, v19, v9, 5
    v_sub_u32 v3, v3, v10
    ds_read_b64 v[18:19], v13 offset:8
    v_add_u32_sdwa v36, -1, v2 dst_sel:BYTE_3 dst_unused:UNUSED_PAD src0_sel:DWORD src1_sel:DWORD
    v_add_u32_sdwa v37, -2, v2 dst_sel:BYTE_3 dst_unused:UNUSED_PAD src0_sel:DWORD src1_sel:DWORD
    v_add_u32_sdwa v38, -3, v2 dst_sel:BYTE_3 dst_unused:UNUSED_PAD src0_sel:DWORD src1_sel:DWORD
    v_add_u32_sdwa v39, -4, v2 dst_sel:BYTE_3 dst_unused:UNUSED_PAD src0_sel:DWORD src1_sel:DWORD
    v_add_u32_sdwa v40, -1, v3 dst_sel:BYTE_3 dst_unused:UNUSED_PAD src0_sel:DWORD src1_sel:DWORD
    v_add_u32_sdwa v41, -2, v3 dst_sel:BYTE_3 dst_unused:UNUSED_PAD src0_sel:DWORD src1_sel:DWORD
    v_add_u32_sdwa v42, -3, v3 dst_sel:BYTE_3 dst_unused:UNUSED_PAD src0_sel:DWORD src1_sel:DWORD
    v_add_u32_sdwa v43, -4, v3 dst_sel:BYTE_3 dst_unused:UNUSED_PAD src0_sel:DWORD src1_sel:DWORD
    v_add_u32 v13, 8, v13
    v_add_u32 v32, s56, v26
    v_add_u32 v33, s56, v27
    s_addk_i32 s56, 0x4000
    s_bitset0_b32 s56, 16
    s_waitcnt lgkmcnt(11)
    v_mfma_f32_16x16x32_bf16 v[56:59], v[48:51], v[44:47], v[56:59]
    s_waitcnt lgkmcnt(9)
    v_mfma_f32_16x16x32_bf16 v[60:63], v[52:55], v[44:47], v[60:63]
    s_waitcnt lgkmcnt(8)
    v_mfma_f32_16x16x32_bf16 v[36:39], v[80:83], v[64:67], v[36:39]
    s_waitcnt lgkmcnt(7)
    v_mfma_f32_16x16x32_bf16 v[40:43], v[96:99], v[64:67], v[40:43]
    s_waitcnt lgkmcnt(6)
    v_mfma_f32_16x16x32_bf16 v[36:39], v[84:87], v[68:71], v[36:39]
    s_waitcnt lgkmcnt(5)
    v_mfma_f32_16x16x32_bf16 v[40:43], v[100:103], v[68:71], v[40:43]
    s_waitcnt lgkmcnt(4)
    v_mfma_f32_16x16x32_bf16 v[36:39], v[88:91], v[72:75], v[36:39]
    s_waitcnt lgkmcnt(3)
    v_mfma_f32_16x16x32_bf16 v[40:43], v[104:107], v[72:75], v[40:43]
    s_waitcnt lgkmcnt(2)
    v_mfma_f32_16x16x32_bf16 v[36:39], v[92:95], v[76:79], v[36:39]
    s_waitcnt lgkmcnt(1)
    v_mfma_f32_16x16x32_bf16 v[40:43], v[108:111], v[76:79], v[40:43]
    v_add_u32 v28, s56, v22
    v_add_u32 v29, s56, v23
    v_add_u32 v30, s56, v24
    v_add_u32 v31, s56, v25
    s_nop 3
    v_max3_f32 v2, v36, v37, v38
    v_max3_f32 v3, v40, v41, v42
    v_max3_f32 v2, v2, v39, v6
    v_max3_f32 v2, v2, v3, v43
    v_cmp_gt_f32 vcc, v2, v6
    s_cbranch_vccz L_skip
    v_mov_b32 v3, v2
    s_nop 1
    v_permlane32_swap_b32 v2, v3
    s_nop 0
    v_max_f32 v2, v2, v3
    v_mov_b32 v3, v2
    s_nop 1
    v_permlane16_swap_b32 v2, v3
    s_nop 0
    v_max_f32 v2, v2, v3
    v_sub_f32 v12, v6, v2
    v_mul_f32 v12, s53, v12
    v_exp_f32 v12, v12
    v_mov_b32 v6, v2
    v_mul_f32 v8, s53, v2
    v_mul_f32 v7, v7, v12
    v_mul_f32 v56, v56, v12
    v_mul_f32 v57, v57, v12
    v_mul_f32 v58, v58, v12
    v_mul_f32 v59, v59, v12
    v_mul_f32 v60, v60, v12
    v_mul_f32 v61, v61, v12
    v_mul_f32 v62, v62, v12
    v_mul_f32 v63, v63, v12
L_skip:
    v_fma_f32 v36, v36, s53, -v8
    v_fma_f32 v37, v37, s53, -v8
    v_fma_f32 v38, v38, s53, -v8
    v_fma_f32 v39, v39, s53, -v8
    v_fma_f32 v40, v40, s53, -v8
    v_fma_f32 v41, v41, s53, -v8
    v_fma_f32 v42, v42, s53, -v8
    v_fma_f32 v43, v43, s53, -v8
    v_exp_f32 v36, v36
    v_exp_f32 v37, v37
    v_exp_f32 v38, v38
    v_exp_f32 v39, v39
    v_exp_f32 v40, v40
    s_branch L_over3
L_touch3:
    s_branch L_eb
L_over3:
    v_exp_f32 v41, v41
    v_exp_f32 v42, v42
    v_exp_f32 v43, v43
    s_cmp_lt_u32 s54, s55
    v_cvt_pk_bf16_f32 v44, v36, v37
    v_cvt_pk_bf16_f32 v45, v38, v39
    v_cvt_pk_bf16_f32 v46, v40, v41
    v_cvt_pk_bf16_f32 v47, v42, v43
    v_pk_add_f32 v[36:37], v[36:37], v[38:39]
    v_pk_add_f32 v[40:41], v[40:41], v[42:43]
    v_pk_add_f32 v[36:37], v[36:37], v[40:41]
    v_add_f32 v7, v7, v36
    v_add_f32 v7, v7, v37
    s_waitcnt lgkmcnt(0)
    s_cbranch_scc1 L_noproc
    s_cmp_eq_u32 s54, s55
    s_cbranch_scc1 L_req
    s_xor_b32 s59, s73, s72
    s_lshl_b32 s6, s59, 8
    s_cbranch_scc1 L_done
    s_lshr_b32 s6, s59, 23
    s_lshr_b32 s59, s59, 24
    s_cmp_ge_u32 s6, s57
    s_cbranch_scc1 L_done
    s_lshl_b64 exec, 1, s59
    ds_write2_b32 v14, v16, v17 offset0:0 offset1:1
    s_mov_b64 exec, -1
    v_add_u32 v14, 8, v14
    s_add_u32 s6, s6, 2
    s_cmp_lt_u32 s6, s57
    s_waitcnt lgkmcnt(0)
    s_cbranch_scc0 L_done
L_req:
    s_lshl_b32 s73, 1, 24
    s_waitcnt vmcnt(0)
    s_atomic_add s73, s[22:23], s58 glc
    s_branch L_noproc
L_done:
    s_brev_b32 s55, -2
L_noproc:
    v_readfirstlane_b32 s59, v18
    s_add_u32 s54, s54, 1
    s_cmp_lg_u32 s59, 0
    s_cbranch_scc1 L_r
    v_mov_b32 v3, v7
    s_mov_b32 vcc_lo, 0xff00ff00
    s_mov_b32 vcc_hi, vcc_lo
    v_permlane32_swap_b32 v7, v3
    s_add_u32 s42, s42, 0x6b43a9b5
    v_add_f32 v7, v7, v3
    v_mov_b32 v3, v7
    s_nop 1
    v_permlane16_swap_b32 v7, v3
    v_mov_b32 v39, s42
    v_add_f32 v7, v7, v3
    v_max_f32 v7, 0xda24260, v7
    v_rcp_f32 v12, v7
    v_log_f32 v7, v7
    s_waitcnt vmcnt(0)
    v_add_f32 v38, v8, v7
    s_barrier
    ds_read_b64_tr_b16 v[48:49], v32 offset:8192
    ds_read_b64_tr_b16 v[50:51], v32 offset:12288
    ds_read_b64_tr_b16 v[52:53], v33 offset:8192
    ds_read_b64_tr_b16 v[54:55], v33 offset:12288
    s_waitcnt lgkmcnt(2)
    v_mfma_f32_16x16x32_bf16 v[56:59], v[48:51], v[44:47], v[56:59]
    s_waitcnt lgkmcnt(0)
    v_mfma_f32_16x16x32_bf16 v[60:63], v[52:55], v[44:47], v[60:63]
    s_nop 7
    v_cndmask_b32 v56, v56, v60, vcc
    v_cndmask_b32 v57, v57, v61, vcc
    v_cndmask_b32 v58, v58, v62, vcc
    v_cndmask_b32 v59, v59, v63, vcc
    v_mul_f32 v56, v56, v12
    v_mul_f32 v57, v57, v12
    v_mul_f32 v58, v58, v12
    v_mul_f32 v59, v59, v12
    v_cvt_pk_bf16_f32 v36, v56, v57
    v_cvt_pk_bf16_f32 v37, v58, v59
    buffer_store_dwordx4 v[36:39], v20, s[44:47], s70 offen sc1
    s_waitcnt vmcnt(0)
    s_barrier
    s_endpgm
.section .rodata,"a"
.p2align 6
.amdhsa_kernel standalone__paged_block_table_kv_radixattention__decode_kernel
  .amdhsa_next_free_vgpr 112
  .amdhsa_next_free_sgpr 96
  .amdhsa_accum_offset 112
  .amdhsa_group_segment_fixed_size 0
  .amdhsa_kernarg_size 64
  .amdhsa_user_sgpr_count 2
  .amdhsa_user_sgpr_kernarg_segment_ptr 1
  .amdhsa_system_sgpr_workgroup_id_x 1
.end_amdhsa_kernel
```
